```python
import torch

def _softmax(x, axis=-1):
    return torch.softmax(x, dim=axis)
def _gelu(x):
    return torch.nn.functional.gelu(x, approximate="tanh")
def _silu(x):
    return torch.nn.functional.silu(x)
def _sigmoid(x):
    return torch.sigmoid(x)
def _layernorm(x, axis=-1, eps=1e-5):
    m = x.mean(dim=axis, keepdim=True)
    v = x.var(dim=axis, keepdim=True, unbiased=False)
    return (x - m) / torch.sqrt(v + eps)
def _scatter_add(tgt, idx, src, axis=0):
    return tgt.clone().index_add_(axis, idx, src)
def _segment_sum(src, seg, n):
    out = torch.zeros((n,) + src.shape[1:], dtype=src.dtype)
    return out.index_add_(0, seg, src)
def _pad(x, pw):
    flat = tuple(v for pair in reversed(pw) for v in pair)
    return torch.nn.functional.pad(x, flat)

kernel_name = 'standalone__low_rank_proj_linformer__decode'

def setup_inputs():

    _w = (lambda a: (lambda t: t.to(torch.bfloat16) if t.is_floating_point() else t)(torch.as_tensor(a)))
    B, H, Sq, Skv, Dh, R = 1, 32, 1, 4096, 192, 64
    return {
        "q": _w((lambda *s: torch.randn(*s, dtype=torch.bfloat16) * 0.8)(B, H, Sq, Dh)),
        "k": _w((lambda *s: torch.randn(*s, dtype=torch.bfloat16) * 0.8)(B, H, Skv, Dh)),
        "v": _w((lambda *s: torch.randn(*s, dtype=torch.bfloat16) * 0.05)(B, H, Skv, Dh)),
        "e_proj": _w((lambda *s: torch.randn(*s, dtype=torch.bfloat16) * 0.8)(R, Skv) * (Skv ** -0.5)),
        "f_proj": _w((lambda *s: torch.randn(*s, dtype=torch.bfloat16) * 0.05)(R, Skv) * (Skv ** -0.5)),
    }

def reference(q, k, v, e_proj, f_proj):
    B, H, Sq, Dh = q.shape
    kp = torch.einsum("rn,bhnd->bhrd", e_proj, k)
    vp = torch.einsum("rn,bhnd->bhrd", f_proj, v)
    scores = torch.einsum("bhqd,bhrd->bhqr", q, kp) * (Dh ** -0.5)
    p = _softmax(scores, axis=-1)
    o = torch.einsum("bhqr,bhrd->bhqd", p, vp)
    return o
```

```asm
; @launch grid=(256,1,1) block=(576,1,1) lds=50448
.amdgcn_target "amdgcn-amd-amdhsa--gfx950"
.text
.globl standalone__low_rank_proj_linformer__decode_kernel
.p2align 8
.type standalone__low_rank_proj_linformer__decode_kernel,@function
standalone__low_rank_proj_linformer__decode_kernel:
  s_cmp_ge_u32 s2, 256
  s_cbranch_scc1 L_end
  s_load_dwordx16 s[4:19], s[0:1], 0
  v_lshrrev_b32 v1, 6, v0
  v_and_b32 v0, 63, v0
  s_and_b32 s36, s2, 7
  v_readfirstlane_b32 s3, v1
  s_lshr_b32 s37, s2, 3
  s_lshl_b32 s33, s36, 5
  s_add_u32 s33, s33, s37
  s_cmp_eq_u32 s3, 8
  s_cbranch_scc1 L_ctrl
  v_lshrrev_b32 v2, 3, v0
  v_and_b32 v3, 7, v0
  v_lshlrev_b32 v144, 4, v3
  v_mul_u32_u24 v1, 3072, v2
  v_add_u32 v1, v1, v144
  s_lshr_b32 s38, s3, 1
  s_and_b32 s39, s3, 1
  s_lshl_b32 s40, s36, 2
  s_add_u32 s40, s40, s38
  s_mul_i32 s41, s40, 1572864
  s_mul_i32 s42, s37, 49152
  s_add_u32 s41, s41, s42
  s_mul_i32 s42, s39, 24576
  s_add_u32 s41, s41, s42
  s_mul_i32 s42, s40, 384
  s_mov_b32 s22, 24576
  s_mov_b32 s23, 0x20000
  s_waitcnt lgkmcnt(0)
  s_add_u32 s20, s6, s41
  s_addc_u32 s21, s7, 0
  buffer_load_dwordx4 v[132:135], v1, s[20:23], 0 offen offset:0 nt
  buffer_load_dwordx4 v[136:139], v1, s[20:23], 0 offen offset:128 nt
  s_add_u32 s4, s4, s42
  s_addc_u32 s5, s5, 0
  global_load_dwordx4 v[4:7], v144, s[4:5] offset:0
  global_load_dwordx4 v[8:11], v144, s[4:5] offset:128
  global_load_dwordx4 v[12:15], v144, s[4:5] offset:256
  buffer_load_dwordx4 v[140:143], v1, s[20:23], 0 offen offset:256 nt
  s_add_u32 s24, s8, s41
  s_addc_u32 s25, s9, 0
  s_mov_b32 s26, 24576
  s_mov_b32 s27, 0x20000
  s_mul_i32 s47, s38, 544
  s_lshl_b32 s48, s39, 7
  s_add_u32 s47, s47, s48
  s_add_u32 s47, s47, 47104
  v_lshlrev_b32 v146, 1, v0
  v_add_u32 v146, s47, v146
  v_and_b32 v147, 1, v0
  v_cmp_eq_u32 vcc, 1, v147
  v_mov_b32 v148, 0xffff
  v_mov_b32 v149, 0xffff0000
  v_cndmask_b32 v147, v148, v149, vcc
  v_lshrrev_b32 v148, 1, v3
  v_cmp_eq_u32 vcc, 0, v148
  s_nop 1
  v_cndmask_b32 v152, 0, v147, vcc
  v_cmp_eq_u32 vcc, 1, v148
  s_nop 1
  v_cndmask_b32 v153, 0, v147, vcc
  v_cmp_eq_u32 vcc, 2, v148
  s_nop 1
  v_cndmask_b32 v154, 0, v147, vcc
  v_cmp_eq_u32 vcc, 3, v148
  s_nop 1
  v_cndmask_b32 v155, 0, v147, vcc
  s_lshl_b32 s47, s38, 9
  s_lshl_b32 s48, s39, 8
  s_add_u32 s47, s47, s48
  s_add_u32 s47, s47, 45056
  v_lshlrev_b32 v150, 5, v2
  v_add_u32 v150, s47, v150
  s_mul_i32 s47, s38, 3072
  s_mul_i32 s48, s39, 1536
  s_add_u32 s47, s47, s48
  s_add_u32 s47, s47, 32768
  v_bfe_u32 v151, v0, 3, 1
  v_mul_u32_u24 v151, 768, v151
  v_lshl_add_u32 v151, v3, 5, v151
  v_bfe_u32 v2, v0, 4, 1
  v_lshl_add_u32 v151, v2, 4, v151
  v_add_u32 v151, s47, v151
  v_mov_b32 v2, 50432
  v_mov_b32 v3, 1
  s_mov_b32 s40, 0x01010101
  s_mov_b32 s41, 0x01010101
  s_barrier
  s_waitcnt vmcnt(1)
  v_dot2_f32_bf16 v144, v132, v4, 0
  v_dot2_f32_bf16 v144, v133, v5, v144
  v_dot2_f32_bf16 v144, v134, v6, v144
  v_dot2_f32_bf16 v144, v135, v7, v144
  buffer_load_dwordx4 v[132:135], v1, s[20:23], 0 offen offset:384 nt
  v_dot2_f32_bf16 v144, v136, v8, v144
  v_dot2_f32_bf16 v144, v137, v9, v144
  v_dot2_f32_bf16 v144, v138, v10, v144
  v_dot2_f32_bf16 v144, v139, v11, v144
  buffer_load_dwordx4 v[136:139], v1, s[20:23], 0 offen offset:512 nt
  s_waitcnt vmcnt(2)
  v_dot2_f32_bf16 v144, v140, v12, v144
  v_dot2_f32_bf16 v144, v141, v13, v144
  v_dot2_f32_bf16 v144, v142, v14, v144
  v_dot2_f32_bf16 v144, v143, v15, v144
  buffer_load_dwordx4 v[140:143], v1, s[20:23], 0 offen offset:640 nt
  s_nop 1
  v_add_f32_dpp v144, v144, v144 quad_perm:[1,0,3,2] row_mask:0xf bank_mask:0xf
  s_nop 1
  v_add_f32_dpp v144, v144, v144 quad_perm:[2,3,0,1] row_mask:0xf bank_mask:0xf
  s_nop 1
  v_add_f32_dpp v144, v144, v144 row_half_mirror row_mask:0xf bank_mask:0xf
  v_cndmask_b32 v145, v145, v144, s[40:41]
  s_lshl_b64 s[40:41], s[40:41], 1
  s_waitcnt vmcnt(2)
  v_dot2_f32_bf16 v144, v132, v4, 0
  v_dot2_f32_bf16 v144, v133, v5, v144
  v_dot2_f32_bf16 v144, v134, v6, v144
  v_dot2_f32_bf16 v144, v135, v7, v144
  buffer_load_dwordx4 v[132:135], v1, s[20:23], 0 offen offset:768 nt
  s_waitcnt vmcnt(2)
  v_dot2_f32_bf16 v144, v136, v8, v144
  v_dot2_f32_bf16 v144, v137, v9, v144
  v_dot2_f32_bf16 v144, v138, v10, v144
  v_dot2_f32_bf16 v144, v139, v11, v144
  buffer_load_dwordx4 v[136:139], v1, s[20:23], 0 offen offset:896 nt
  s_waitcnt vmcnt(2)
  v_dot2_f32_bf16 v144, v140, v12, v144
  v_dot2_f32_bf16 v144, v141, v13, v144
  v_dot2_f32_bf16 v144, v142, v14, v144
  v_dot2_f32_bf16 v144, v143, v15, v144
  buffer_load_dwordx4 v[140:143], v1, s[20:23], 0 offen offset:1024 nt
  s_nop 1
  v_add_f32_dpp v144, v144, v144 quad_perm:[1,0,3,2] row_mask:0xf bank_mask:0xf
  s_nop 1
  v_add_f32_dpp v144, v144, v144 quad_perm:[2,3,0,1] row_mask:0xf bank_mask:0xf
  s_nop 1
  v_add_f32_dpp v144, v144, v144 row_half_mirror row_mask:0xf bank_mask:0xf
  v_cndmask_b32 v145, v145, v144, s[40:41]
  s_lshl_b64 s[40:41], s[40:41], 1
  s_waitcnt vmcnt(2)
  v_dot2_f32_bf16 v144, v132, v4, 0
  v_dot2_f32_bf16 v144, v133, v5, v144
  v_dot2_f32_bf16 v144, v134, v6, v144
  v_dot2_f32_bf16 v144, v135, v7, v144
  buffer_load_dwordx4 v[132:135], v1, s[20:23], 0 offen offset:1152 nt
  s_waitcnt vmcnt(2)
  v_dot2_f32_bf16 v144, v136, v8, v144
  v_dot2_f32_bf16 v144, v137, v9, v144
  v_dot2_f32_bf16 v144, v138, v10, v144
  v_dot2_f32_bf16 v144, v139, v11, v144
  buffer_load_dwordx4 v[136:139], v1, s[20:23], 0 offen offset:1280 nt
  s_waitcnt vmcnt(2)
  v_dot2_f32_bf16 v144, v140, v12, v144
  v_dot2_f32_bf16 v144, v141, v13, v144
  v_dot2_f32_bf16 v144, v142, v14, v144
  v_dot2_f32_bf16 v144, v143, v15, v144
  buffer_load_dwordx4 v[140:143], v1, s[20:23], 0 offen offset:1408 nt
  s_nop 1
  v_add_f32_dpp v144, v144, v144 quad_perm:[1,0,3,2] row_mask:0xf bank_mask:0xf
  s_nop 1
  v_add_f32_dpp v144, v144, v144 quad_perm:[2,3,0,1] row_mask:0xf bank_mask:0xf
  s_nop 1
  v_add_f32_dpp v144, v144, v144 row_half_mirror row_mask:0xf bank_mask:0xf
  v_cndmask_b32 v145, v145, v144, s[40:41]
  s_lshl_b64 s[40:41], s[40:41], 1
  s_waitcnt vmcnt(2)
  v_dot2_f32_bf16 v144, v132, v4, 0
  v_dot2_f32_bf16 v144, v133, v5, v144
  v_dot2_f32_bf16 v144, v134, v6, v144
  v_dot2_f32_bf16 v144, v135, v7, v144
  buffer_load_dwordx4 v[132:135], v1, s[20:23], 0 offen offset:1536 nt
  s_waitcnt vmcnt(2)
  v_dot2_f32_bf16 v144, v136, v8, v144
  v_dot2_f32_bf16 v144, v137, v9, v144
  v_dot2_f32_bf16 v144, v138, v10, v144
  v_dot2_f32_bf16 v144, v139, v11, v144
  buffer_load_dwordx4 v[136:139], v1, s[20:23], 0 offen offset:1664 nt
  s_waitcnt vmcnt(2)
  v_dot2_f32_bf16 v144, v140, v12, v144
  v_dot2_f32_bf16 v144, v141, v13, v144
  v_dot2_f32_bf16 v144, v142, v14, v144
  v_dot2_f32_bf16 v144, v143, v15, v144
  buffer_load_dwordx4 v[140:143], v1, s[20:23], 0 offen offset:1792 nt
  s_nop 1
  v_add_f32_dpp v144, v144, v144 quad_perm:[1,0,3,2] row_mask:0xf bank_mask:0xf
  s_nop 1
  v_add_f32_dpp v144, v144, v144 quad_perm:[2,3,0,1] row_mask:0xf bank_mask:0xf
  s_nop 1
  v_add_f32_dpp v144, v144, v144 row_half_mirror row_mask:0xf bank_mask:0xf
  v_cndmask_b32 v145, v145, v144, s[40:41]
  s_lshl_b64 s[40:41], s[40:41], 1
  s_waitcnt vmcnt(2)
  v_dot2_f32_bf16 v144, v132, v4, 0
  v_dot2_f32_bf16 v144, v133, v5, v144
  v_dot2_f32_bf16 v144, v134, v6, v144
  v_dot2_f32_bf16 v144, v135, v7, v144
  buffer_load_dwordx4 v[132:135], v1, s[20:23], 0 offen offset:1920 nt
  s_waitcnt vmcnt(2)
  v_dot2_f32_bf16 v144, v136, v8, v144
  v_dot2_f32_bf16 v144, v137, v9, v144
  v_dot2_f32_bf16 v144, v138, v10, v144
  v_dot2_f32_bf16 v144, v139, v11, v144
  buffer_load_dwordx4 v[136:139], v1, s[20:23], 0 offen offset:2048 nt
  s_waitcnt vmcnt(2)
  v_dot2_f32_bf16 v144, v140, v12, v144
  v_dot2_f32_bf16 v144, v141, v13, v144
  v_dot2_f32_bf16 v144, v142, v14, v144
  v_dot2_f32_bf16 v144, v143, v15, v144
  buffer_load_dwordx4 v[140:143], v1, s[20:23], 0 offen offset:2176 nt
  s_nop 1
  v_add_f32_dpp v144, v144, v144 quad_perm:[1,0,3,2] row_mask:0xf bank_mask:0xf
  s_nop 1
  v_add_f32_dpp v144, v144, v144 quad_perm:[2,3,0,1] row_mask:0xf bank_mask:0xf
  s_nop 1
  v_add_f32_dpp v144, v144, v144 row_half_mirror row_mask:0xf bank_mask:0xf
  v_cndmask_b32 v145, v145, v144, s[40:41]
  s_lshl_b64 s[40:41], s[40:41], 1
  s_waitcnt vmcnt(2)
  v_dot2_f32_bf16 v144, v132, v4, 0
  v_dot2_f32_bf16 v144, v133, v5, v144
  v_dot2_f32_bf16 v144, v134, v6, v144
  v_dot2_f32_bf16 v144, v135, v7, v144
  buffer_load_dwordx4 v[132:135], v1, s[20:23], 0 offen offset:2304 nt
  s_waitcnt vmcnt(2)
  v_dot2_f32_bf16 v144, v136, v8, v144
  v_dot2_f32_bf16 v144, v137, v9, v144
  v_dot2_f32_bf16 v144, v138, v10, v144
  v_dot2_f32_bf16 v144, v139, v11, v144
  buffer_load_dwordx4 v[136:139], v1, s[20:23], 0 offen offset:2432 nt
  s_waitcnt vmcnt(2)
  v_dot2_f32_bf16 v144, v140, v12, v144
  v_dot2_f32_bf16 v144, v141, v13, v144
  v_dot2_f32_bf16 v144, v142, v14, v144
  v_dot2_f32_bf16 v144, v143, v15, v144
  buffer_load_dwordx4 v[140:143], v1, s[20:23], 0 offen offset:2560 nt
  s_nop 1
  v_add_f32_dpp v144, v144, v144 quad_perm:[1,0,3,2] row_mask:0xf bank_mask:0xf
  s_nop 1
  v_add_f32_dpp v144, v144, v144 quad_perm:[2,3,0,1] row_mask:0xf bank_mask:0xf
  s_nop 1
  v_add_f32_dpp v144, v144, v144 row_half_mirror row_mask:0xf bank_mask:0xf
  v_cndmask_b32 v145, v145, v144, s[40:41]
  s_lshl_b64 s[40:41], s[40:41], 1
  s_waitcnt vmcnt(2)
  v_dot2_f32_bf16 v144, v132, v4, 0
  v_dot2_f32_bf16 v144, v133, v5, v144
  v_dot2_f32_bf16 v144, v134, v6, v144
  v_dot2_f32_bf16 v144, v135, v7, v144
  buffer_load_dwordx4 v[132:135], v1, s[20:23], 0 offen offset:2688 nt
  s_waitcnt vmcnt(2)
  v_dot2_f32_bf16 v144, v136, v8, v144
  v_dot2_f32_bf16 v144, v137, v9, v144
  v_dot2_f32_bf16 v144, v138, v10, v144
  v_dot2_f32_bf16 v144, v139, v11, v144
  buffer_load_dwordx4 v[136:139], v1, s[20:23], 0 offen offset:2816 nt
  s_waitcnt vmcnt(2)
  v_dot2_f32_bf16 v144, v140, v12, v144
  v_dot2_f32_bf16 v144, v141, v13, v144
  v_dot2_f32_bf16 v144, v142, v14, v144
  v_dot2_f32_bf16 v144, v143, v15, v144
  buffer_load_dwordx4 v[140:143], v1, s[20:23], 0 offen offset:2944 nt
  s_nop 1
  v_add_f32_dpp v144, v144, v144 quad_perm:[1,0,3,2] row_mask:0xf bank_mask:0xf
  s_nop 1
  v_add_f32_dpp v144, v144, v144 quad_perm:[2,3,0,1] row_mask:0xf bank_mask:0xf
  s_nop 1
  v_add_f32_dpp v144, v144, v144 row_half_mirror row_mask:0xf bank_mask:0xf
  v_cndmask_b32 v145, v145, v144, s[40:41]
  s_lshl_b64 s[40:41], s[40:41], 1
  s_waitcnt vmcnt(2)
  v_dot2_f32_bf16 v144, v132, v4, 0
  v_dot2_f32_bf16 v144, v133, v5, v144
  v_dot2_f32_bf16 v144, v134, v6, v144
  v_dot2_f32_bf16 v144, v135, v7, v144
  buffer_load_dwordx4 v[48:51], v1, s[24:27], 0 offen offset:0 nt
  s_waitcnt vmcnt(2)
  v_dot2_f32_bf16 v144, v136, v8, v144
  v_dot2_f32_bf16 v144, v137, v9, v144
  v_dot2_f32_bf16 v144, v138, v10, v144
  v_dot2_f32_bf16 v144, v139, v11, v144
  buffer_load_dwordx4 v[52:55], v1, s[24:27], 0 offen offset:128 nt
  s_waitcnt vmcnt(2)
  v_dot2_f32_bf16 v144, v140, v12, v144
  v_dot2_f32_bf16 v144, v141, v13, v144
  v_dot2_f32_bf16 v144, v142, v14, v144
  v_dot2_f32_bf16 v144, v143, v15, v144
  buffer_load_dwordx4 v[56:59], v1, s[24:27], 0 offen offset:256 nt
  s_nop 1
  v_add_f32_dpp v144, v144, v144 quad_perm:[1,0,3,2] row_mask:0xf bank_mask:0xf
  s_nop 1
  v_add_f32_dpp v144, v144, v144 quad_perm:[2,3,0,1] row_mask:0xf bank_mask:0xf
  s_nop 1
  v_add_f32_dpp v144, v144, v144 row_half_mirror row_mask:0xf bank_mask:0xf
  v_cndmask_b32 v145, v145, v144, s[40:41]
  s_lshl_b64 s[40:41], s[40:41], 1
  v_cvt_pk_bf16_f32 v147, v145, v145
  v_and_b32 v148, 0xffff0000, v147
  v_sub_f32 v148, v145, v148
  v_cvt_pk_bf16_f32 v148, v148, v148
  ds_write_b16 v146, v147
  ds_write_b16 v146, v148 offset:272
  s_mov_b64 exec, 1
  ds_add_u32 v2, v3
  s_mov_b64 exec, -1
  s_waitcnt vmcnt(2)
  buffer_load_dwordx4 v[60:63], v1, s[24:27], 0 offen offset:384 nt
  s_waitcnt vmcnt(2)
  buffer_load_dwordx4 v[64:67], v1, s[24:27], 0 offen offset:512 nt
  s_waitcnt vmcnt(2)
  buffer_load_dwordx4 v[68:71], v1, s[24:27], 0 offen offset:640 nt
  s_waitcnt vmcnt(2)
  buffer_load_dwordx4 v[72:75], v1, s[24:27], 0 offen offset:768 nt
  s_waitcnt vmcnt(2)
  buffer_load_dwordx4 v[76:79], v1, s[24:27], 0 offen offset:896 nt
  s_waitcnt vmcnt(2)
  buffer_load_dwordx4 v[80:83], v1, s[24:27], 0 offen offset:1024 nt
  s_waitcnt vmcnt(2)
  buffer_load_dwordx4 v[84:87], v1, s[24:27], 0 offen offset:1152 nt
  s_waitcnt vmcnt(2)
  buffer_load_dwordx4 v[88:91], v1, s[24:27], 0 offen offset:1280 nt
  s_waitcnt vmcnt(2)
  buffer_load_dwordx4 v[92:95], v1, s[24:27], 0 offen offset:1408 nt
  s_waitcnt vmcnt(2)
  buffer_load_dwordx4 v[96:99], v1, s[24:27], 0 offen offset:1536 nt
  s_waitcnt vmcnt(2)
  buffer_load_dwordx4 v[100:103], v1, s[24:27], 0 offen offset:1664 nt
  s_waitcnt vmcnt(2)
  buffer_load_dwordx4 v[104:107], v1, s[24:27], 0 offen offset:1792 nt
  s_waitcnt vmcnt(2)
  buffer_load_dwordx4 v[108:111], v1, s[24:27], 0 offen offset:1920 nt
  s_waitcnt vmcnt(2)
  buffer_load_dwordx4 v[112:115], v1, s[24:27], 0 offen offset:2048 nt
  s_waitcnt vmcnt(2)
  buffer_load_dwordx4 v[116:119], v1, s[24:27], 0 offen offset:2176 nt
  s_waitcnt vmcnt(2)
  buffer_load_dwordx4 v[120:123], v1, s[24:27], 0 offen offset:2304 nt
  s_waitcnt vmcnt(2)
  buffer_load_dwordx4 v[124:127], v1, s[24:27], 0 offen offset:2432 nt
  s_waitcnt vmcnt(2)
  buffer_load_dwordx4 v[128:131], v1, s[24:27], 0 offen offset:2560 nt
  s_waitcnt vmcnt(2)
  buffer_load_dwordx4 v[132:135], v1, s[24:27], 0 offen offset:2688 nt
  s_waitcnt vmcnt(2)
  buffer_load_dwordx4 v[136:139], v1, s[24:27], 0 offen offset:2816 nt
  s_waitcnt vmcnt(2)
  buffer_load_dwordx4 v[140:143], v1, s[24:27], 0 offen offset:2944 nt
  s_barrier
  ds_read_b128 v[4:7], v150
  ds_read_b128 v[8:11], v150 offset:16
  s_waitcnt lgkmcnt(1)
  v_cvt_pk_bf16_f32 v146, v4, v4
  v_and_b32 v16, v146, v152
  v_and_b32 v17, v146, v153
  v_and_b32 v18, v146, v154
  v_and_b32 v19, v146, v155
  v_cvt_pk_bf16_f32 v146, v5, v5
  v_and_b32 v20, v146, v152
  v_and_b32 v21, v146, v153
  v_and_b32 v22, v146, v154
  v_and_b32 v23, v146, v155
  v_cvt_pk_bf16_f32 v146, v6, v6
  v_and_b32 v24, v146, v152
  v_and_b32 v25, v146, v153
  v_and_b32 v26, v146, v154
  v_and_b32 v27, v146, v155
  v_cvt_pk_bf16_f32 v146, v7, v7
  v_and_b32 v28, v146, v152
  v_and_b32 v29, v146, v153
  v_and_b32 v30, v146, v154
  v_and_b32 v31, v146, v155
  s_waitcnt lgkmcnt(0)
  v_cvt_pk_bf16_f32 v146, v8, v8
  v_and_b32 v32, v146, v152
  v_and_b32 v33, v146, v153
  v_and_b32 v34, v146, v154
  v_and_b32 v35, v146, v155
  v_cvt_pk_bf16_f32 v146, v9, v9
  v_and_b32 v36, v146, v152
  v_and_b32 v37, v146, v153
  v_and_b32 v38, v146, v154
  v_and_b32 v39, v146, v155
  v_cvt_pk_bf16_f32 v146, v10, v10
  v_and_b32 v40, v146, v152
  v_and_b32 v41, v146, v153
  v_and_b32 v42, v146, v154
  v_and_b32 v43, v146, v155
  v_cvt_pk_bf16_f32 v146, v11, v11
  v_and_b32 v44, v146, v152
  v_and_b32 v45, v146, v153
  v_and_b32 v46, v146, v154
  v_and_b32 v47, v146, v155
  v_mfma_f32_16x16x32_bf16 v[156:159], v[16:19], v[48:51], 0
  v_mfma_f32_16x16x32_bf16 v[160:163], v[16:19], v[52:55], 0
  v_mfma_f32_16x16x32_bf16 v[164:167], v[16:19], v[56:59], 0
  v_mfma_f32_16x16x32_bf16 v[156:159], v[20:23], v[60:63], v[156:159]
  v_mfma_f32_16x16x32_bf16 v[160:163], v[20:23], v[64:67], v[160:163]
  v_mfma_f32_16x16x32_bf16 v[164:167], v[20:23], v[68:71], v[164:167]
  v_mfma_f32_16x16x32_bf16 v[156:159], v[24:27], v[72:75], v[156:159]
  v_mfma_f32_16x16x32_bf16 v[160:163], v[24:27], v[76:79], v[160:163]
  v_mfma_f32_16x16x32_bf16 v[164:167], v[24:27], v[80:83], v[164:167]
  v_mfma_f32_16x16x32_bf16 v[156:159], v[28:31], v[84:87], v[156:159]
  v_mfma_f32_16x16x32_bf16 v[160:163], v[28:31], v[88:91], v[160:163]
  v_mfma_f32_16x16x32_bf16 v[164:167], v[28:31], v[92:95], v[164:167]
  v_mfma_f32_16x16x32_bf16 v[156:159], v[32:35], v[96:99], v[156:159]
  v_mfma_f32_16x16x32_bf16 v[160:163], v[32:35], v[100:103], v[160:163]
  v_mfma_f32_16x16x32_bf16 v[164:167], v[32:35], v[104:107], v[164:167]
  v_mfma_f32_16x16x32_bf16 v[156:159], v[36:39], v[108:111], v[156:159]
  v_mfma_f32_16x16x32_bf16 v[160:163], v[36:39], v[112:115], v[160:163]
  v_mfma_f32_16x16x32_bf16 v[164:167], v[36:39], v[116:119], v[164:167]
  v_mfma_f32_16x16x32_bf16 v[156:159], v[40:43], v[120:123], v[156:159]
  v_mfma_f32_16x16x32_bf16 v[160:163], v[40:43], v[124:127], v[160:163]
  v_mfma_f32_16x16x32_bf16 v[164:167], v[40:43], v[128:131], v[164:167]
  s_waitcnt vmcnt(0)
  v_mfma_f32_16x16x32_bf16 v[156:159], v[44:47], v[132:135], v[156:159]
  v_mfma_f32_16x16x32_bf16 v[160:163], v[44:47], v[136:139], v[160:163]
  v_mfma_f32_16x16x32_bf16 v[164:167], v[44:47], v[140:143], v[164:167]
  s_mov_b32 exec_lo, 0x00ff00ff
  s_mov_b32 exec_hi, 0xff00ff00
  s_nop 5
  ds_write_b128 v151, v[156:159] offset:0
  ds_write_b128 v151, v[160:163] offset:256
  ds_write_b128 v151, v[164:167] offset:512
  s_mov_b64 exec, -1
  s_waitcnt lgkmcnt(0)
  s_barrier
  s_endpgm
L_ctrl:
  s_setprio 3
  s_getreg_b32 s52, hwreg(HW_REG_XCC_ID, 0, 4)
  s_mov_b32 s54, 0
  v_mov_b32 v14, 50432
  v_mov_b32 v15, 0
  ds_write_b32 v14, v15
  s_waitcnt lgkmcnt(0)
  s_barrier
  s_add_u32 s20, s18, 251658240
  s_addc_u32 s21, s19, 0
  s_lshl_b32 s38, s36, 7
  v_mov_b32 v15, s38
  global_load_dword v16, v15, s[20:21] sc1
  s_lshl_b32 s38, s37, 8
  s_add_u32 s24, s10, s38
  s_addc_u32 s25, s11, 0
  s_sub_u32 s26, 524288, s38
  s_mov_b32 s27, 0x20000
  s_add_u32 s28, s12, s38
  s_addc_u32 s29, s13, 0
  s_sub_u32 s30, 524288, s38
  s_mov_b32 s31, 0x20000
  v_lshrrev_b32 v14, 4, v0
  v_and_b32 v15, 15, v0
  v_xor_b32 v2, v14, v15
  v_lshlrev_b32 v2, 4, v2
  v_lshl_add_u32 v2, v14, 13, v2
  v_xor_b32 v3, 64, v2
  v_xor_b32 v4, 128, v2
  v_xor_b32 v5, 192, v2
  v_lshlrev_b32 v6, 1, v14
  v_xor_b32 v6, v6, v15
  v_lshlrev_b32 v6, 4, v6
  v_lshl_add_u32 v6, v14, 13, v6
  v_xor_b32 v7, 128, v6
  s_mov_b32 m0, 0
  s_mov_b32 s38, 0
  buffer_load_dwordx4 v2, s[24:27], s38 offen  lds
  s_mov_b32 m0, 1024
  s_mov_b32 s38, 32768
  buffer_load_dwordx4 v3, s[24:27], s38 offen  lds
  s_mov_b32 m0, 2048
  s_mov_b32 s38, 65536
  buffer_load_dwordx4 v4, s[24:27], s38 offen  lds
  s_mov_b32 m0, 3072
  s_mov_b32 s38, 98304
  buffer_load_dwordx4 v5, s[24:27], s38 offen  lds
  v_xor_b32 v8, v14, v15
  v_lshlrev_b32 v8, 4, v8
  v_lshl_add_u32 v8, v15, 8, v8
  v_xor_b32 v9, 64, v8
  v_xor_b32 v10, 128, v8
  v_xor_b32 v11, 192, v8
  v_and_b32 v12, 7, v15
  v_mul_u32_u24 v12, 272, v12
  v_lshl_add_u32 v12, v14, 4, v12
  v_add_u32 v12, 47104, v12
  v_bfe_u32 v13, v0, 2, 2
  v_lshl_add_u32 v17, v14, 3, v13
  v_lshlrev_b32 v17, 8, v17
  v_and_b32 v18, 1, v14
  v_lshl_add_u32 v18, v18, 2, v13
  v_lshl_add_u32 v17, v18, 5, v17
  v_and_b32 v18, 3, v0
  v_lshl_add_u32 v17, v18, 3, v17
  v_add_u32 v13, 16384, v17
  v_lshrrev_b32 v17, 1, v15
  v_lshlrev_b32 v17, 8, v17
  v_and_b32 v18, 1, v15
  v_lshl_add_u32 v17, v18, 6, v17
  v_lshl_add_u32 v17, v14, 4, v17
  s_lshl_b32 s38, s33, 10
  s_add_u32 s38, s38, 65536
  v_add_u32 v160, s38, v17
  v_add_u32 v161, 128, v160
  v_and_b32 v17, 31, v0
  v_lshlrev_b32 v17, 10, v17
  v_lshrrev_b32 v18, 5, v0
  v_lshl_add_u32 v17, v18, 4, v17
  s_lshl_b32 s38, s36, 15
  s_lshl_b32 s39, s37, 5
  s_add_u32 s38, s38, s39
  s_add_u32 s38, s38, 65536
  v_add_u32 v162, s38, v17
  s_mul_i32 s38, s36, 4096
  s_add_u32 s38, s38, 524288
  s_mul_i32 s39, s37, 128
  s_add_u32 s39, s39, s38
  v_lshrrev_b32 v18, 5, v0
  v_lshlrev_b32 v17, 4, v18
  v_add_u32 v163, s39, v17
  v_lshrrev_b32 v17, 1, v0
  v_mul_u32_u24 v17, 128, v17
  v_and_b32 v18, 1, v0
  v_lshl_add_u32 v17, v18, 4, v17
  v_add_u32 v164, s38, v17
  v_mul_u32_u24 v17, 288, v14
  v_lshl_add_u32 v17, v15, 3, v17
  v_add_u32 v165, 49280, v17
  v_and_b32 v17, 7, v15
  v_mul_u32_u24 v17, 144, v17
  v_lshl_add_u32 v17, v14, 4, v17
  v_add_u32 v166, 49280, v17
  v_lshrrev_b32 v17, 1, v15
  v_lshlrev_b32 v17, 9, v17
  v_lshl_add_u32 v17, v14, 4, v17
  v_add_u32 v167, 45056, v17
  v_and_b32 v17, 1, v0
  v_cmp_eq_u32 s[44:45], 1, v17
  v_mov_b32 v1, 0xffffff00
  s_waitcnt vmcnt(3)
  v_readfirstlane_b32 s51, v16
  s_add_u32 s51, s51, 1
  s_and_b32 s50, s51, 0xff
  s_and_b32 s52, s52, 7
  s_and_b32 s53, s50, 0xf8
  s_or_b32 s53, s53, s52
  s_mov_b32 m0, 4096
  s_mov_b32 s38, 131072
  buffer_load_dwordx4 v2, s[24:27], s38 offen  lds
  s_waitcnt vmcnt(3)
  s_mov_b32 m0, 5120
  s_mov_b32 s38, 163840
  buffer_load_dwordx4 v3, s[24:27], s38 offen  lds
  s_waitcnt vmcnt(3)
  s_mov_b32 m0, 6144
  s_mov_b32 s38, 196608
  buffer_load_dwordx4 v4, s[24:27], s38 offen  lds
  s_waitcnt vmcnt(3)
  s_mov_b32 m0, 7168
  s_mov_b32 s38, 229376
  buffer_load_dwordx4 v5, s[24:27], s38 offen  lds
  s_waitcnt vmcnt(3)
  s_mov_b32 m0, 8192
  s_mov_b32 s38, 262144
  buffer_load_dwordx4 v2, s[24:27], s38 offen  lds
  s_waitcnt vmcnt(3)
  s_mov_b32 m0, 9216
  s_mov_b32 s38, 294912
  buffer_load_dwordx4 v3, s[24:27], s38 offen  lds
  s_waitcnt vmcnt(3)
  s_mov_b32 m0, 10240
  s_mov_b32 s38, 327680
  buffer_load_dwordx4 v4, s[24:27], s38 offen  lds
  s_waitcnt vmcnt(3)
  s_mov_b32 m0, 11264
  s_mov_b32 s38, 360448
  buffer_load_dwordx4 v5, s[24:27], s38 offen  lds
  s_waitcnt vmcnt(3)
  s_mov_b32 m0, 12288
  s_mov_b32 s38, 393216
  buffer_load_dwordx4 v2, s[24:27], s38 offen  lds
  s_waitcnt vmcnt(3)
  s_mov_b32 m0, 13312
  s_mov_b32 s38, 425984
  buffer_load_dwordx4 v3, s[24:27], s38 offen  lds
  s_waitcnt vmcnt(3)
  s_mov_b32 m0, 14336
  s_mov_b32 s38, 458752
  buffer_load_dwordx4 v4, s[24:27], s38 offen  lds
  s_waitcnt vmcnt(3)
  s_mov_b32 m0, 15360
  s_mov_b32 s38, 491520
  buffer_load_dwordx4 v5, s[24:27], s38 offen  lds
  s_waitcnt vmcnt(3)
  s_mov_b32 m0, 16384
  s_mov_b32 s38, 0
  buffer_load_dwordx4 v6, s[28:31], s38 offen  lds
  s_waitcnt vmcnt(3)
  s_mov_b32 m0, 17408
  s_mov_b32 s38, 32768
  buffer_load_dwordx4 v6, s[28:31], s38 offen  lds
  s_waitcnt vmcnt(3)
  s_mov_b32 m0, 18432
  s_mov_b32 s38, 65536
  buffer_load_dwordx4 v7, s[28:31], s38 offen  lds
  s_waitcnt vmcnt(3)
  ds_read_b128 v[32:35], v8 offset:0
  ds_read_b128 v[36:39], v9 offset:0
  ds_read_b128 v[40:43], v10 offset:0
  ds_read_b128 v[44:47], v11 offset:0
  ds_read_b128 v[48:51], v8 offset:4096
  ds_read_b128 v[52:55], v9 offset:4096
  ds_read_b128 v[56:59], v10 offset:4096
  ds_read_b128 v[60:63], v11 offset:4096
  ds_read_b128 v[64:67], v8 offset:8192
  ds_read_b128 v[68:71], v9 offset:8192
  ds_read_b128 v[72:75], v10 offset:8192
  ds_read_b128 v[76:79], v11 offset:8192
  ds_read_b128 v[80:83], v8 offset:12288
  ds_read_b128 v[84:87], v9 offset:12288
  ds_read_b128 v[88:91], v10 offset:12288
  ds_read_b128 v[92:95], v11 offset:12288
  s_mov_b32 m0, 19456
  s_mov_b32 s38, 98304
  buffer_load_dwordx4 v7, s[28:31], s38 offen  lds
  s_waitcnt vmcnt(3)
  s_mov_b32 m0, 20480
  s_mov_b32 s38, 131072
  buffer_load_dwordx4 v6, s[28:31], s38 offen  lds
  s_waitcnt vmcnt(3)
  s_mov_b32 m0, 21504
  s_mov_b32 s38, 163840
  buffer_load_dwordx4 v6, s[28:31], s38 offen  lds
  s_waitcnt vmcnt(3)
  s_mov_b32 m0, 22528
  s_mov_b32 s38, 196608
  buffer_load_dwordx4 v7, s[28:31], s38 offen  lds
  s_waitcnt vmcnt(3)
  s_mov_b32 m0, 23552
  s_mov_b32 s38, 229376
  buffer_load_dwordx4 v7, s[28:31], s38 offen  lds
  s_waitcnt vmcnt(3)
  s_mov_b32 m0, 24576
  s_mov_b32 s38, 262144
  buffer_load_dwordx4 v6, s[28:31], s38 offen  lds
  s_waitcnt vmcnt(3)
  s_mov_b32 m0, 25600
  s_mov_b32 s38, 294912
  buffer_load_dwordx4 v6, s[28:31], s38 offen  lds
  s_waitcnt vmcnt(3)
  s_mov_b32 m0, 26624
  s_mov_b32 s38, 327680
  buffer_load_dwordx4 v7, s[28:31], s38 offen  lds
  s_waitcnt vmcnt(3)
  s_mov_b32 m0, 27648
  s_mov_b32 s38, 360448
  buffer_load_dwordx4 v7, s[28:31], s38 offen  lds
  s_waitcnt vmcnt(3)
  s_mov_b32 m0, 28672
  s_mov_b32 s38, 393216
  buffer_load_dwordx4 v6, s[28:31], s38 offen  lds
  s_waitcnt vmcnt(3)
  s_mov_b32 m0, 29696
  s_mov_b32 s38, 425984
  buffer_load_dwordx4 v6, s[28:31], s38 offen  lds
  s_waitcnt vmcnt(3)
  s_mov_b32 m0, 30720
  s_mov_b32 s38, 458752
  buffer_load_dwordx4 v7, s[28:31], s38 offen  lds
  s_waitcnt vmcnt(3)
  s_mov_b32 m0, 31744
  s_mov_b32 s38, 491520
  buffer_load_dwordx4 v7, s[28:31], s38 offen  lds
  s_waitcnt vmcnt(0)
  s_waitcnt lgkmcnt(0)
  v_mov_b32 v14, 50432
  s_mov_b32 s30, 0
L_spin:
  ds_read_b32 v17, v14
  s_waitcnt lgkmcnt(0)
  v_readfirstlane_b32 s31, v17
  s_add_u32 s30, s30, 1
  s_cmp_gt_u32 s30, 320000
  s_cbranch_scc1 L_spin_done
  s_cmp_ge_u32 s31, 8
  s_cbranch_scc1 L_spin_done
  s_sleep 1
  s_branch L_spin
L_spin_done:
  ds_read_b128 v[128:131], v12 offset:0
  ds_read_b128 v[132:135], v12 offset:64
  ds_read_b128 v[136:139], v12 offset:128
  ds_read_b128 v[140:143], v12 offset:192
  s_waitcnt lgkmcnt(3)
  v_mfma_f32_16x16x32_bf16 v[16:19], v[32:35], v[128:131], 0
  v_mfma_f32_16x16x32_bf16 v[20:23], v[48:51], v[128:131], 0
  v_mfma_f32_16x16x32_bf16 v[24:27], v[64:67], v[128:131], 0
  v_mfma_f32_16x16x32_bf16 v[28:31], v[80:83], v[128:131], 0
  s_waitcnt lgkmcnt(2)
  v_mfma_f32_16x16x32_bf16 v[16:19], v[36:39], v[132:135], v[16:19]
  v_mfma_f32_16x16x32_bf16 v[20:23], v[52:55], v[132:135], v[20:23]
  v_mfma_f32_16x16x32_bf16 v[24:27], v[68:71], v[132:135], v[24:27]
  v_mfma_f32_16x16x32_bf16 v[28:31], v[84:87], v[132:135], v[28:31]
  s_waitcnt lgkmcnt(1)
  v_mfma_f32_16x16x32_bf16 v[16:19], v[40:43], v[136:139], v[16:19]
  v_mfma_f32_16x16x32_bf16 v[20:23], v[56:59], v[136:139], v[20:23]
  v_mfma_f32_16x16x32_bf16 v[24:27], v[72:75], v[136:139], v[24:27]
  v_mfma_f32_16x16x32_bf16 v[28:31], v[88:91], v[136:139], v[28:31]
  s_waitcnt lgkmcnt(0)
  v_mfma_f32_16x16x32_bf16 v[16:19], v[44:47], v[140:143], v[16:19]
  v_mfma_f32_16x16x32_bf16 v[20:23], v[60:63], v[140:143], v[20:23]
  v_mfma_f32_16x16x32_bf16 v[24:27], v[76:79], v[140:143], v[24:27]
  v_mfma_f32_16x16x32_bf16 v[28:31], v[92:95], v[140:143], v[28:31]
  s_nop 7
  v_add_f32_dpp v16, v16, v16 quad_perm:[1,0,3,2] row_mask:0xf bank_mask:0xf
  v_add_f32_dpp v17, v17, v17 quad_perm:[1,0,3,2] row_mask:0xf bank_mask:0xf
  v_add_f32_dpp v18, v18, v18 quad_perm:[1,0,3,2] row_mask:0xf bank_mask:0xf
  v_add_f32_dpp v19, v19, v19 quad_perm:[1,0,3,2] row_mask:0xf bank_mask:0xf
  v_add_f32_dpp v20, v20, v20 quad_perm:[1,0,3,2] row_mask:0xf bank_mask:0xf
  v_add_f32_dpp v21, v21, v21 quad_perm:[1,0,3,2] row_mask:0xf bank_mask:0xf
  v_add_f32_dpp v22, v22, v22 quad_perm:[1,0,3,2] row_mask:0xf bank_mask:0xf
  v_add_f32_dpp v23, v23, v23 quad_perm:[1,0,3,2] row_mask:0xf bank_mask:0xf
  v_add_f32_dpp v24, v24, v24 quad_perm:[1,0,3,2] row_mask:0xf bank_mask:0xf
  v_add_f32_dpp v25, v25, v25 quad_perm:[1,0,3,2] row_mask:0xf bank_mask:0xf
  v_add_f32_dpp v26, v26, v26 quad_perm:[1,0,3,2] row_mask:0xf bank_mask:0xf
  v_add_f32_dpp v27, v27, v27 quad_perm:[1,0,3,2] row_mask:0xf bank_mask:0xf
  v_add_f32_dpp v28, v28, v28 quad_perm:[1,0,3,2] row_mask:0xf bank_mask:0xf
  v_add_f32_dpp v29, v29, v29 quad_perm:[1,0,3,2] row_mask:0xf bank_mask:0xf
  v_add_f32_dpp v30, v30, v30 quad_perm:[1,0,3,2] row_mask:0xf bank_mask:0xf
  v_add_f32_dpp v31, v31, v31 quad_perm:[1,0,3,2] row_mask:0xf bank_mask:0xf
  v_cndmask_b32 v128, v16, v20, s[44:45]
  v_cndmask_b32 v129, v17, v21, s[44:45]
  v_cndmask_b32 v130, v18, v22, s[44:45]
  v_cndmask_b32 v131, v19, v23, s[44:45]
  v_cndmask_b32 v132, v24, v28, s[44:45]
  v_cndmask_b32 v133, v25, v29, s[44:45]
  v_cndmask_b32 v134, v26, v30, s[44:45]
  v_cndmask_b32 v135, v27, v31, s[44:45]
  v_and_or_b32 v128, v128, v1, s50
  v_and_or_b32 v129, v129, v1, s50
  v_and_or_b32 v130, v130, v1, s50
  v_and_or_b32 v131, v131, v1, s53
  v_and_or_b32 v132, v132, v1, s50
  v_and_or_b32 v133, v133, v1, s50
  v_and_or_b32 v134, v134, v1, s50
  v_and_or_b32 v135, v135, v1, s53
  s_mov_b32 exec_lo, 0x00ff00ff
  s_mov_b32 exec_hi, 0x00ff00ff
  global_store_dwordx4 v160, v[128:131], s[20:21]
  global_store_dwordx4 v161, v[132:135], s[20:21]
  s_mov_b64 exec, -1
  s_mov_b32 s30, 0
  global_load_dwordx4 v[144:147], v162, s[20:21] sc1
  ds_read_b64_tr_b16 v[32:33], v13 offset:0
  ds_read_b64_tr_b16 v[34:35], v13 offset:1024
  ds_read_b64_tr_b16 v[36:37], v13 offset:8192
  ds_read_b64_tr_b16 v[38:39], v13 offset:9216
  v_xor_b32 v17, 32, v13
  ds_read_b64_tr_b16 v[40:41], v17 offset:0
  ds_read_b64_tr_b16 v[42:43], v17 offset:1024
  ds_read_b64_tr_b16 v[44:45], v17 offset:8192
  ds_read_b64_tr_b16 v[46:47], v17 offset:9216
  v_xor_b32 v17, 64, v13
  ds_read_b64_tr_b16 v[48:49], v17 offset:0
  ds_read_b64_tr_b16 v[50:51], v17 offset:1024
  ds_read_b64_tr_b16 v[52:53], v17 offset:8192
  ds_read_b64_tr_b16 v[54:55], v17 offset:9216
  v_xor_b32 v17, 96, v13
  ds_read_b64_tr_b16 v[56:57], v17 offset:0
  ds_read_b64_tr_b16 v[58:59], v17 offset:1024
  ds_read_b64_tr_b16 v[60:61], v17 offset:8192
  ds_read_b64_tr_b16 v[62:63], v17 offset:9216
  v_xor_b32 v17, 128, v13
  ds_read_b64_tr_b16 v[64:65], v17 offset:0
  ds_read_b64_tr_b16 v[66:67], v17 offset:1024
  ds_read_b64_tr_b16 v[68:69], v17 offset:8192
  ds_read_b64_tr_b16 v[70:71], v17 offset:9216
  v_xor_b32 v17, 160, v13
  ds_read_b64_tr_b16 v[72:73], v17 offset:0
  ds_read_b64_tr_b16 v[74:75], v17 offset:1024
  ds_read_b64_tr_b16 v[76:77], v17 offset:8192
  ds_read_b64_tr_b16 v[78:79], v17 offset:9216
  v_xor_b32 v17, 192, v13
  ds_read_b64_tr_b16 v[80:81], v17 offset:0
  ds_read_b64_tr_b16 v[82:83], v17 offset:1024
  ds_read_b64_tr_b16 v[84:85], v17 offset:8192
  ds_read_b64_tr_b16 v[86:87], v17 offset:9216
  v_xor_b32 v17, 224, v13
  ds_read_b64_tr_b16 v[88:89], v17 offset:0
  ds_read_b64_tr_b16 v[90:91], v17 offset:1024
  ds_read_b64_tr_b16 v[92:93], v17 offset:8192
  ds_read_b64_tr_b16 v[94:95], v17 offset:9216
L_p1a:
  s_waitcnt vmcnt(0)
  v_bitop3_b32 v14, v144, v145, s50 bitop3:0x7e
  v_xor_b32 v15, s50, v146
  v_or_b32 v14, v14, v15
  v_xor_b32 v15, s50, v147
  v_and_b32 v15, 0xf8, v15
  v_or_b32 v14, v14, v15
  v_and_b32 v14, 0xff, v14
  v_cmp_ne_u32 vcc, 0, v14
  s_add_u32 s30, s30, 1
  s_cmp_gt_u32 s30, 40000
  s_cbranch_scc1 L_p1a_d
  s_cbranch_vccz L_p1a_d
  s_cmp_eq_u32 s30, 24
  s_cbranch_scc1 L_rep_tmo
L_rep_tmo_bk:
  global_load_dwordx4 v[144:147], v162, s[20:21] sc1
  s_branch L_p1a
L_p1a_d:
  v_xor_b32 v14, s53, v147
  v_and_b32 v14, 7, v14
  v_cmp_ne_u32 vcc, 0, v14
  s_cbranch_vccnz L_rep_die
L_rep_die_bk:
  v_and_b32 v144, v144, v1
  v_and_b32 v145, v145, v1
  v_and_b32 v146, v146, v1
  v_and_b32 v147, v147, v1
  v_add_f32_dpp v144, v144, v144 quad_perm:[1,0,3,2] row_mask:0xf bank_mask:0xf
  v_add_f32_dpp v145, v145, v145 quad_perm:[1,0,3,2] row_mask:0xf bank_mask:0xf
  v_add_f32_dpp v146, v146, v146 quad_perm:[1,0,3,2] row_mask:0xf bank_mask:0xf
  v_add_f32_dpp v147, v147, v147 quad_perm:[1,0,3,2] row_mask:0xf bank_mask:0xf
  v_add_f32_dpp v144, v144, v144 quad_perm:[2,3,0,1] row_mask:0xf bank_mask:0xf
  v_add_f32_dpp v145, v145, v145 quad_perm:[2,3,0,1] row_mask:0xf bank_mask:0xf
  v_add_f32_dpp v146, v146, v146 quad_perm:[2,3,0,1] row_mask:0xf bank_mask:0xf
  v_add_f32_dpp v147, v147, v147 quad_perm:[2,3,0,1] row_mask:0xf bank_mask:0xf
  v_add_f32_dpp v144, v144, v144 row_half_mirror row_mask:0xf bank_mask:0xf
  v_add_f32_dpp v145, v145, v145 row_half_mirror row_mask:0xf bank_mask:0xf
  v_add_f32_dpp v146, v146, v146 row_half_mirror row_mask:0xf bank_mask:0xf
  v_add_f32_dpp v147, v147, v147 row_half_mirror row_mask:0xf bank_mask:0xf
  v_add_f32_dpp v144, v144, v144 row_mirror row_mask:0xf bank_mask:0xf
  v_add_f32_dpp v145, v145, v145 row_mirror row_mask:0xf bank_mask:0xf
  v_add_f32_dpp v146, v146, v146 row_mirror row_mask:0xf bank_mask:0xf
  v_add_f32_dpp v147, v147, v147 row_mirror row_mask:0xf bank_mask:0xf
  v_add_f32_dpp v144, v144, v144 row_bcast:15 row_mask:0xa bank_mask:0xf
  v_add_f32_dpp v145, v145, v145 row_bcast:15 row_mask:0xa bank_mask:0xf
  v_add_f32_dpp v146, v146, v146 row_bcast:15 row_mask:0xa bank_mask:0xf
  v_add_f32_dpp v147, v147, v147 row_bcast:15 row_mask:0xa bank_mask:0xf
  v_and_or_b32 v144, v144, v1, s50
  v_and_or_b32 v145, v145, v1, s50
  v_and_or_b32 v146, v146, v1, s50
  v_and_or_b32 v147, v147, v1, s50
  s_mov_b32 exec_lo, 0x80000000
  s_mov_b32 exec_hi, 0x80000000
  s_cmp_lg_u32 s54, 0
  s_cbranch_scc1 L_s1b_wt
  global_store_dwordx4 v163, v[144:147], s[20:21]
L_s1b_bk:
  s_mov_b64 exec, -1
  s_mov_b32 s30, 0
  global_load_dwordx4 v[148:151], v164, s[20:21] sc1
L_p1b:
  s_waitcnt vmcnt(0)
  v_bitop3_b32 v14, v148, v149, s50 bitop3:0x7e
  v_bitop3_b32 v15, v150, v151, s50 bitop3:0x7e
  v_or_b32 v14, v14, v15
  v_and_b32 v14, 0xff, v14
  v_cmp_ne_u32 vcc, 0, v14
  s_add_u32 s30, s30, 1
  s_cmp_gt_u32 s30, 40000
  s_cbranch_scc1 L_p1b_d
  s_cbranch_vccz L_p1b_d
  global_load_dwordx4 v[148:151], v164, s[20:21] sc1
  s_branch L_p1b
L_p1b_d:
  s_mov_b32 s38, 0x3dd53b95
  v_and_b32 v148, v148, v1
  v_and_b32 v149, v149, v1
  v_and_b32 v150, v150, v1
  v_and_b32 v151, v151, v1
  v_mul_f32 v148, s38, v148
  v_mul_f32 v149, s38, v149
  v_mul_f32 v150, s38, v150
  v_mul_f32 v151, s38, v151
  v_max_f32 v24, v148, v149
  v_max3_f32 v24, v150, v151, v24
  s_nop 1
  v_max_f32_dpp v24, v24, v24 quad_perm:[1,0,3,2] row_mask:0xf bank_mask:0xf
  s_nop 1
  v_max_f32_dpp v24, v24, v24 quad_perm:[2,3,0,1] row_mask:0xf bank_mask:0xf
  s_nop 1
  v_max_f32_dpp v24, v24, v24 row_half_mirror row_mask:0xf bank_mask:0xf
  s_nop 1
  v_max_f32_dpp v24, v24, v24 row_mirror row_mask:0xf bank_mask:0xf
  v_sub_f32 v148, v148, v24
  v_sub_f32 v149, v149, v24
  v_sub_f32 v150, v150, v24
  v_sub_f32 v151, v151, v24
  v_exp_f32 v148, v148
  v_exp_f32 v149, v149
  v_exp_f32 v150, v150
  v_exp_f32 v151, v151
  s_nop 0
  v_add_f32 v24, v148, v149
  v_add_f32 v25, v150, v151
  v_add_f32 v24, v24, v25
  s_nop 1
  v_add_f32_dpp v24, v24, v24 quad_perm:[1,0,3,2] row_mask:0xf bank_mask:0xf
  s_nop 1
  v_add_f32_dpp v24, v24, v24 quad_perm:[2,3,0,1] row_mask:0xf bank_mask:0xf
  s_nop 1
  v_add_f32_dpp v24, v24, v24 row_half_mirror row_mask:0xf bank_mask:0xf
  s_nop 1
  v_add_f32_dpp v24, v24, v24 row_mirror row_mask:0xf bank_mask:0xf
  v_rcp_f32 v24, v24
  s_nop 0
  v_mul_f32 v148, v148, v24
  v_mul_f32 v149, v149, v24
  v_mul_f32 v150, v150, v24
  v_mul_f32 v151, v151, v24
  v_cvt_pk_bf16_f32 v26, v148, v149
  v_cvt_pk_bf16_f32 v27, v150, v151
  v_lshlrev_b32 v28, 16, v26
  v_and_b32 v29, 0xffff0000, v26
  v_lshlrev_b32 v30, 16, v27
  v_and_b32 v31, 0xffff0000, v27
  v_sub_f32 v28, v148, v28
  v_sub_f32 v29, v149, v29
  v_sub_f32 v30, v150, v30
  v_sub_f32 v31, v151, v31
  v_cvt_pk_bf16_f32 v28, v28, v29
  v_cvt_pk_bf16_f32 v29, v30, v31
  ds_write_b64 v165, v[26:27]
  ds_write_b64 v165, v[28:29] offset:144
  s_waitcnt lgkmcnt(0)
  ds_read_b128 v[128:131], v166
  ds_read_b128 v[132:135], v166 offset:64
  s_waitcnt lgkmcnt(1)
  v_mfma_f32_16x16x32_bf16 v[96:99], v[32:35], v[128:131], 0
  v_mfma_f32_16x16x32_bf16 v[100:103], v[40:43], v[128:131], 0
  v_mfma_f32_16x16x32_bf16 v[104:107], v[48:51], v[128:131], 0
  v_mfma_f32_16x16x32_bf16 v[108:111], v[56:59], v[128:131], 0
  v_mfma_f32_16x16x32_bf16 v[112:115], v[64:67], v[128:131], 0
  v_mfma_f32_16x16x32_bf16 v[116:119], v[72:75], v[128:131], 0
  v_mfma_f32_16x16x32_bf16 v[120:123], v[80:83], v[128:131], 0
  v_mfma_f32_16x16x32_bf16 v[124:127], v[88:91], v[128:131], 0
  s_waitcnt lgkmcnt(0)
  v_mfma_f32_16x16x32_bf16 v[96:99], v[36:39], v[132:135], v[96:99]
  v_mfma_f32_16x16x32_bf16 v[100:103], v[44:47], v[132:135], v[100:103]
  v_mfma_f32_16x16x32_bf16 v[104:107], v[52:55], v[132:135], v[104:107]
  v_mfma_f32_16x16x32_bf16 v[108:111], v[60:63], v[132:135], v[108:111]
  v_mfma_f32_16x16x32_bf16 v[112:115], v[68:71], v[132:135], v[112:115]
  v_mfma_f32_16x16x32_bf16 v[116:119], v[76:79], v[132:135], v[116:119]
  v_mfma_f32_16x16x32_bf16 v[120:123], v[84:87], v[132:135], v[120:123]
  v_mfma_f32_16x16x32_bf16 v[124:127], v[92:95], v[132:135], v[124:127]
  s_mov_b32 s46, 0x00550055
  s_mov_b32 s47, 0x00550055
  s_nop 5
  v_add_f32_dpp v96, v96, v96 quad_perm:[1,0,3,2] row_mask:0xf bank_mask:0xf
  v_add_f32_dpp v97, v97, v97 quad_perm:[1,0,3,2] row_mask:0xf bank_mask:0xf
  v_add_f32_dpp v98, v98, v98 quad_perm:[1,0,3,2] row_mask:0xf bank_mask:0xf
  v_add_f32_dpp v99, v99, v99 quad_perm:[1,0,3,2] row_mask:0xf bank_mask:0xf
  v_add_f32_dpp v100, v100, v100 quad_perm:[1,0,3,2] row_mask:0xf bank_mask:0xf
  v_add_f32_dpp v101, v101, v101 quad_perm:[1,0,3,2] row_mask:0xf bank_mask:0xf
  v_add_f32_dpp v102, v102, v102 quad_perm:[1,0,3,2] row_mask:0xf bank_mask:0xf
  v_add_f32_dpp v103, v103, v103 quad_perm:[1,0,3,2] row_mask:0xf bank_mask:0xf
  v_add_f32_dpp v104, v104, v104 quad_perm:[1,0,3,2] row_mask:0xf bank_mask:0xf
  v_add_f32_dpp v105, v105, v105 quad_perm:[1,0,3,2] row_mask:0xf bank_mask:0xf
  v_add_f32_dpp v106, v106, v106 quad_perm:[1,0,3,2] row_mask:0xf bank_mask:0xf
  v_add_f32_dpp v107, v107, v107 quad_perm:[1,0,3,2] row_mask:0xf bank_mask:0xf
  v_add_f32_dpp v108, v108, v108 quad_perm:[1,0,3,2] row_mask:0xf bank_mask:0xf
  v_add_f32_dpp v109, v109, v109 quad_perm:[1,0,3,2] row_mask:0xf bank_mask:0xf
  v_add_f32_dpp v110, v110, v110 quad_perm:[1,0,3,2] row_mask:0xf bank_mask:0xf
  v_add_f32_dpp v111, v111, v111 quad_perm:[1,0,3,2] row_mask:0xf bank_mask:0xf
  v_add_f32_dpp v112, v112, v112 quad_perm:[1,0,3,2] row_mask:0xf bank_mask:0xf
  v_add_f32_dpp v113, v113, v113 quad_perm:[1,0,3,2] row_mask:0xf bank_mask:0xf
  v_add_f32_dpp v114, v114, v114 quad_perm:[1,0,3,2] row_mask:0xf bank_mask:0xf
  v_add_f32_dpp v115, v115, v115 quad_perm:[1,0,3,2] row_mask:0xf bank_mask:0xf
  v_add_f32_dpp v116, v116, v116 quad_perm:[1,0,3,2] row_mask:0xf bank_mask:0xf
  v_add_f32_dpp v117, v117, v117 quad_perm:[1,0,3,2] row_mask:0xf bank_mask:0xf
  v_add_f32_dpp v118, v118, v118 quad_perm:[1,0,3,2] row_mask:0xf bank_mask:0xf
  v_add_f32_dpp v119, v119, v119 quad_perm:[1,0,3,2] row_mask:0xf bank_mask:0xf
  v_add_f32_dpp v120, v120, v120 quad_perm:[1,0,3,2] row_mask:0xf bank_mask:0xf
  v_add_f32_dpp v121, v121, v121 quad_perm:[1,0,3,2] row_mask:0xf bank_mask:0xf
  v_add_f32_dpp v122, v122, v122 quad_perm:[1,0,3,2] row_mask:0xf bank_mask:0xf
  v_add_f32_dpp v123, v123, v123 quad_perm:[1,0,3,2] row_mask:0xf bank_mask:0xf
  v_add_f32_dpp v124, v124, v124 quad_perm:[1,0,3,2] row_mask:0xf bank_mask:0xf
  v_add_f32_dpp v125, v125, v125 quad_perm:[1,0,3,2] row_mask:0xf bank_mask:0xf
  v_add_f32_dpp v126, v126, v126 quad_perm:[1,0,3,2] row_mask:0xf bank_mask:0xf
  v_add_f32_dpp v127, v127, v127 quad_perm:[1,0,3,2] row_mask:0xf bank_mask:0xf
  s_mov_b64 exec, s[46:47]
  ds_write_b128 v167, v[96:99] offset:0
  ds_write_b128 v167, v[100:103] offset:64
  ds_write_b128 v167, v[104:107] offset:128
  ds_write_b128 v167, v[108:111] offset:192
  ds_write_b128 v167, v[112:115] offset:256
  ds_write_b128 v167, v[116:119] offset:320
  ds_write_b128 v167, v[120:123] offset:384
  ds_write_b128 v167, v[124:127] offset:448
  s_mov_b64 exec, -1
  s_waitcnt lgkmcnt(0)
  s_barrier
  s_mul_i32 s38, s33, 3072
  s_add_u32 s38, s38, 2097152
  v_lshlrev_b32 v159, 7, v0
  v_add_u32 v159, s38, v159
  s_mov_b64 exec, 0xffffff
  global_load_dword v158, v159, s[20:21]
  s_mov_b64 exec, -1
  v_add_u32 v14, 0, v0
  v_mul_u32_u24 v15, 171, v14
  v_lshrrev_b32 v15, 10, v15
  v_lshlrev_b32 v18, 4, v14
  s_mul_i32 s38, s33, 3072
  s_add_u32 s38, s38, 2097152
  v_add_u32 v2, s38, v18
  v_lshrrev_b32 v15, 3, v15
  v_mul_u32_u24 v17, 48, v15
  v_sub_u32 v17, v14, v17
  v_mul_u32_u24 v15, 3072, v15
  v_lshl_add_u32 v15, v17, 4, v15
  v_add_u32 v5, 32768, v15
  v_add_u32 v14, 64, v0
  v_mul_u32_u24 v15, 171, v14
  v_lshrrev_b32 v15, 10, v15
  v_lshlrev_b32 v18, 4, v14
  s_mul_i32 s38, s33, 3072
  s_add_u32 s38, s38, 2097152
  v_add_u32 v3, s38, v18
  v_lshrrev_b32 v15, 3, v15
  v_mul_u32_u24 v17, 48, v15
  v_sub_u32 v17, v14, v17
  v_mul_u32_u24 v15, 3072, v15
  v_lshl_add_u32 v15, v17, 4, v15
  v_add_u32 v6, 32768, v15
  v_add_u32 v14, 128, v0
  v_mul_u32_u24 v15, 171, v14
  v_lshrrev_b32 v15, 10, v15
  v_lshlrev_b32 v18, 4, v14
  s_mul_i32 s38, s33, 3072
  s_add_u32 s38, s38, 2097152
  v_add_u32 v4, s38, v18
  v_lshrrev_b32 v15, 3, v15
  v_mul_u32_u24 v17, 48, v15
  v_sub_u32 v17, v14, v17
  v_mul_u32_u24 v15, 3072, v15
  v_lshl_add_u32 v15, v17, 4, v15
  v_add_u32 v7, 32768, v15
  v_and_b32 v15, 7, v0
  v_lshrrev_b32 v14, 3, v0
  v_mul_u32_u24 v14, 3072, v14
  v_lshl_add_u32 v14, v15, 4, v14
  s_mul_i32 s38, s36, 98304
  s_mul_i32 s39, s37, 96
  s_add_u32 s38, s38, s39
  s_add_u32 s38, s38, 2097152
  v_add_u32 v8, s38, v14
  v_add_u32 v161, 24576, v8
  v_add_u32 v162, 49152, v8
  v_add_u32 v163, 73728, v8
  s_mul_i32 s38, s36, 1536
  s_mul_i32 s39, s37, 48
  s_add_u32 s38, s38, s39
  s_add_u32 s14, s14, s38
  s_addc_u32 s15, s15, 0
  v_lshlrev_b32 v9, 3, v15
  v_lshrrev_b32 v14, 4, v0
  v_lshl_add_u32 v9, v14, 1, v9
  s_lshl_b32 s38, s36, 7
  v_mov_b32 v10, s38
  v_mov_b32 v11, s51
  s_barrier
  ds_read_b128 v[32:35], v5 offset:0
  ds_read_b128 v[36:39], v5 offset:768
  ds_read_b128 v[40:43], v5 offset:1536
  ds_read_b128 v[44:47], v5 offset:2304
  ds_read_b128 v[48:51], v6 offset:0
  ds_read_b128 v[52:55], v6 offset:768
  ds_read_b128 v[56:59], v6 offset:1536
  ds_read_b128 v[60:63], v6 offset:2304
  ds_read_b128 v[64:67], v7 offset:0
  ds_read_b128 v[68:71], v7 offset:768
  ds_read_b128 v[72:75], v7 offset:1536
  ds_read_b128 v[76:79], v7 offset:2304
  s_waitcnt lgkmcnt(8)
  v_pk_add_f32 v[32:33], v[32:33], v[36:37]
  v_pk_add_f32 v[40:41], v[40:41], v[44:45]
  v_pk_add_f32 v[34:35], v[34:35], v[38:39]
  v_pk_add_f32 v[42:43], v[42:43], v[46:47]
  v_pk_add_f32 v[32:33], v[32:33], v[40:41]
  v_pk_add_f32 v[34:35], v[34:35], v[42:43]
  v_and_or_b32 v32, v32, v1, s50
  v_and_or_b32 v33, v33, v1, s50
  v_and_or_b32 v34, v34, v1, s50
  v_and_or_b32 v35, v35, v1, s50
  s_cmp_lg_u32 s54, 0
  s_cbranch_scc1 L_s2_0_wt
  global_store_dwordx4 v2, v[32:35], s[20:21]
L_s2_0_bk:
  s_waitcnt lgkmcnt(4)
  v_pk_add_f32 v[48:49], v[48:49], v[52:53]
  v_pk_add_f32 v[56:57], v[56:57], v[60:61]
  v_pk_add_f32 v[50:51], v[50:51], v[54:55]
  v_pk_add_f32 v[58:59], v[58:59], v[62:63]
  v_pk_add_f32 v[48:49], v[48:49], v[56:57]
  v_pk_add_f32 v[50:51], v[50:51], v[58:59]
  v_and_or_b32 v48, v48, v1, s50
  v_and_or_b32 v49, v49, v1, s50
  v_and_or_b32 v50, v50, v1, s50
  v_and_or_b32 v51, v51, v1, s50
  s_cmp_lg_u32 s54, 0
  s_cbranch_scc1 L_s2_1_wt
  global_store_dwordx4 v3, v[48:51], s[20:21]
L_s2_1_bk:
  s_waitcnt lgkmcnt(0)
  v_pk_add_f32 v[64:65], v[64:65], v[68:69]
  v_pk_add_f32 v[72:73], v[72:73], v[76:77]
  v_pk_add_f32 v[66:67], v[66:67], v[70:71]
  v_pk_add_f32 v[74:75], v[74:75], v[78:79]
  v_pk_add_f32 v[64:65], v[64:65], v[72:73]
  v_pk_add_f32 v[66:67], v[66:67], v[74:75]
  v_and_or_b32 v64, v64, v1, s50
  v_and_or_b32 v65, v65, v1, s50
  v_and_or_b32 v66, v66, v1, s50
  v_and_or_b32 v67, v67, v1, s50
  s_cmp_lg_u32 s54, 0
  s_cbranch_scc1 L_s2_2_wt
  global_store_dwordx4 v4, v[64:67], s[20:21]
L_s2_2_bk:
  s_mov_b32 exec_lo, 0x3f3f3f3f
  s_mov_b32 exec_hi, 0x3f3f3f3f
  s_mov_b32 s30, 0
  global_load_dwordx4 v[96:99], v8, s[20:21] sc1
  global_load_dwordx4 v[100:103], v161, s[20:21] sc1
  global_load_dwordx4 v[104:107], v162, s[20:21] sc1
  global_load_dwordx4 v[108:111], v163, s[20:21] sc1
L_p2:
  s_waitcnt vmcnt(0)
  v_bitop3_b32 v14, v96, v97, s50 bitop3:0x7e
  v_bitop3_b32 v15, v98, v99, s50 bitop3:0x7e
  v_or_b32 v14, v14, v15
  v_bitop3_b32 v15, v100, v101, s50 bitop3:0x7e
  v_or_b32 v14, v14, v15
  v_bitop3_b32 v15, v102, v103, s50 bitop3:0x7e
  v_or_b32 v14, v14, v15
  v_bitop3_b32 v15, v104, v105, s50 bitop3:0x7e
  v_or_b32 v14, v14, v15
  v_bitop3_b32 v15, v106, v107, s50 bitop3:0x7e
  v_or_b32 v14, v14, v15
  v_bitop3_b32 v15, v108, v109, s50 bitop3:0x7e
  v_or_b32 v14, v14, v15
  v_bitop3_b32 v15, v110, v111, s50 bitop3:0x7e
  v_or_b32 v14, v14, v15
  v_and_b32 v14, 0xff, v14
  v_cmp_ne_u32 vcc, 0, v14
  s_add_u32 s30, s30, 1
  s_cmp_gt_u32 s30, 40000
  s_cbranch_scc1 L_p2_d
  s_cbranch_vccz L_p2_d
  global_load_dwordx4 v[96:99], v8, s[20:21] sc1
  global_load_dwordx4 v[100:103], v161, s[20:21] sc1
  global_load_dwordx4 v[104:107], v162, s[20:21] sc1
  global_load_dwordx4 v[108:111], v163, s[20:21] sc1
  s_branch L_p2
L_p2_d:
  v_and_b32 v96, v96, v1
  v_and_b32 v97, v97, v1
  v_and_b32 v98, v98, v1
  v_and_b32 v99, v99, v1
  v_and_b32 v100, v100, v1
  v_and_b32 v101, v101, v1
  v_and_b32 v102, v102, v1
  v_and_b32 v103, v103, v1
  v_and_b32 v104, v104, v1
  v_and_b32 v105, v105, v1
  v_and_b32 v106, v106, v1
  v_and_b32 v107, v107, v1
  v_and_b32 v108, v108, v1
  v_and_b32 v109, v109, v1
  v_and_b32 v110, v110, v1
  v_and_b32 v111, v111, v1
  v_add_f32 v96, v96, v100
  v_add_f32 v104, v104, v108
  v_add_f32 v97, v97, v101
  v_add_f32 v105, v105, v109
  v_add_f32 v98, v98, v102
  v_add_f32 v106, v106, v110
  v_add_f32 v99, v99, v103
  v_add_f32 v107, v107, v111
  v_add_f32 v96, v96, v104
  v_add_f32 v97, v97, v105
  v_add_f32 v98, v98, v106
  v_add_f32 v99, v99, v107
  s_mov_b64 exec, -1
  v_add_f32_dpp v96, v96, v96 row_ror:8 row_mask:0xf bank_mask:0xf
  v_add_f32_dpp v97, v97, v97 row_ror:8 row_mask:0xf bank_mask:0xf
  v_add_f32_dpp v98, v98, v98 row_ror:8 row_mask:0xf bank_mask:0xf
  v_add_f32_dpp v99, v99, v99 row_ror:8 row_mask:0xf bank_mask:0xf
  s_nop 0
  v_permlane16_swap_b32 v96, v97
  v_permlane16_swap_b32 v98, v99
  v_add_f32 v96, v96, v97
  v_add_f32 v98, v98, v99
  s_nop 1
  v_permlane32_swap_b32 v96, v98
  v_add_f32 v96, v96, v98
  v_cvt_pk_bf16_f32 v96, v96, v96
  s_mov_b32 exec_lo, 0x003f003f
  s_mov_b32 exec_hi, 0x003f003f
  global_store_short v9, v96, s[14:15]
  s_cmp_lg_u32 s37, 0
  s_cbranch_scc1 L_noep
  s_mov_b64 exec, 1
  global_store_dword v10, v11, s[20:21] sc1
L_noep:
L_end:
  s_endpgm
L_s1b_wt:
  global_store_dwordx4 v163, v[144:147], s[20:21] sc1
  s_branch L_s1b_bk
L_s2_0_wt:
  global_store_dwordx4 v2, v[32:35], s[20:21] sc1
  s_branch L_s2_0_bk
L_s2_1_wt:
  global_store_dwordx4 v3, v[48:51], s[20:21] sc1
  s_branch L_s2_1_bk
L_s2_2_wt:
  global_store_dwordx4 v4, v[64:67], s[20:21] sc1
  s_branch L_s2_2_bk
L_rep_tmo:
  s_mov_b32 s54, 1
  s_mov_b32 exec_lo, 0x00ff00ff
  s_mov_b32 exec_hi, 0x00ff00ff
  global_store_dwordx4 v160, v[128:131], s[20:21] sc1
  global_store_dwordx4 v161, v[132:135], s[20:21] sc1
  s_mov_b64 exec, -1
  s_branch L_rep_tmo_bk
L_rep_die:
  s_cmp_lg_u32 s54, 0
  s_cbranch_scc1 L_rep_die_bk
  s_mov_b32 s54, 1
  s_mov_b32 exec_lo, 0x00ff00ff
  s_mov_b32 exec_hi, 0x00ff00ff
  global_store_dwordx4 v160, v[128:131], s[20:21] sc1
  global_store_dwordx4 v161, v[132:135], s[20:21] sc1
  s_mov_b64 exec, -1
  s_branch L_rep_die_bk
.section .rodata,"a"
.p2align 6
.amdhsa_kernel standalone__low_rank_proj_linformer__decode_kernel
  .amdhsa_next_free_vgpr 168
  .amdhsa_next_free_sgpr 96
  .amdhsa_accum_offset 168
  .amdhsa_group_segment_fixed_size 0
  .amdhsa_kernarg_size 64
  .amdhsa_user_sgpr_count 2
  .amdhsa_user_sgpr_kernarg_segment_ptr 1
  .amdhsa_system_sgpr_workgroup_id_x 1
  .amdhsa_float_denorm_mode_32 3
.end_amdhsa_kernel
```
